```python
import torch

def _softmax(x, axis=-1):
    return torch.softmax(x, dim=axis)
def _gelu(x):
    return torch.nn.functional.gelu(x, approximate="tanh")
def _silu(x):
    return torch.nn.functional.silu(x)
def _sigmoid(x):
    return torch.sigmoid(x)
def _layernorm(x, axis=-1, eps=1e-5):
    m = x.mean(dim=axis, keepdim=True)
    v = x.var(dim=axis, keepdim=True, unbiased=False)
    return (x - m) / torch.sqrt(v + eps)
def _scatter_add(tgt, idx, src, axis=0):
    return tgt.clone().index_add_(axis, idx, src)
def _segment_sum(src, seg, n):
    out = torch.zeros((n,) + src.shape[1:], dtype=src.dtype)
    return out.index_add_(0, seg, src)
def _pad(x, pw):
    flat = tuple(v for pair in reversed(pw) for v in pair)
    return torch.nn.functional.pad(x, flat)

kernel_name = 'standalone__paged_block_table_kv_pagedattention__sampling'

def setup_inputs():

    _w = (lambda a: (lambda t: t.to(torch.bfloat16) if t.is_floating_point() else t)(torch.as_tensor(a)))
    B, Hq, Hkv, Sq, Skv, D = 32, 16, 8, 1, 2048, 256
    bs = 16
    nbps = max(1, Skv // bs)
    num_phys = B * nbps + 4
    bt = torch.randperm(num_phys)[: B * nbps].reshape(B, nbps).to(torch.int64)
    cl = (nbps * bs - (torch.arange(1, B + 1, dtype=torch.int64) * 2654435761) % max(1, nbps * bs // 2)).to(torch.int64)
    return {
        "q": _w((lambda *s: torch.randn(*s, dtype=torch.bfloat16) * 0.8)(B, Hq, Sq, D)),
        "k_cache": _w((lambda *s: torch.randn(*s, dtype=torch.bfloat16) * 0.8)(num_phys, bs, Hkv, D)),
        "v_cache": _w((lambda *s: torch.randn(*s, dtype=torch.bfloat16) * 0.05)(num_phys, bs, Hkv, D)),
        "block_table": _w(bt),
        "context_lens": _w(cl),
    }

def reference(q, k_cache, v_cache, block_table, context_lens):
    B, Hq, Sq, D = q.shape
    bs = k_cache.shape[1]
    Hkv = k_cache.shape[2]
    nbps = block_table.shape[1]
    Skv = nbps * bs
    bt = block_table.reshape(-1)
    k = (lambda x, *d: x.permute(*d))(k_cache[bt].reshape(B, Skv, Hkv, D), 0, 2, 1, 3)
    v = (lambda x, *d: x.permute(*d))(v_cache[bt].reshape(B, Skv, Hkv, D), 0, 2, 1, 3)
    g = Hq // Hkv
    qg = q.reshape(B, Hkv, g, Sq, D)
    scores = torch.einsum("bhgqd,bhkd->bhgqk", qg, k) * (D ** -0.5)
    pos = torch.arange(Skv)
    msk = pos[None, :] < context_lens[:, None]
    scores = torch.where(msk[:, None, None, None, :], scores, -1e9)
    p = _softmax(scores, axis=-1)
    out = torch.einsum("bhgqk,bhkd->bhgqd", p, v)
    return out.reshape(B, Hq, Sq, D)
```

```asm
; @launch grid=(256,1,1) block=(512,1,1) lds=143552
.amdgcn_target "amdgcn-amd-amdhsa--gfx950"
.text
.globl standalone__paged_block_table_kv_pagedattention__sampling_kernel
.p2align 8
.type standalone__paged_block_table_kv_pagedattention__sampling_kernel,@function
standalone__paged_block_table_kv_pagedattention__sampling_kernel:
    s_cmp_ge_u32 s2, 256
    s_cbranch_scc1 L_end
    s_load_dwordx16 s[16:31], s[0:1], 0
    v_and_b32 v1, 63, v0
    v_lshrrev_b32 v2, 6, v0
    s_lshr_b32 s60, s2, 3
    s_and_b32 s61, s2, 7
    v_readfirstlane_b32 s12, v2
    s_getpc_b64 s[90:91]
    v_lshlrev_b32 v3, 7, v0
    v_min_u32 v3, L_code_end-standalone__paged_block_table_kv_pagedattention__sampling_kernel-128, v3
    s_cmp_gt_u32 s12, 1
    s_cbranch_scc1 L_nocpf
    global_load_dword v246, v3, s[90:91]
L_nocpf:
    v_lshlrev_b32 v32, 4, v1
    v_lshlrev_b32 v9, 2, v1
    s_and_b32 s62, s12, 3
    s_cmp_lt_u32 s12, 4
    s_cselect_b32 s7, 0, 1
    s_mul_i32 s64, s62, 31744
    s_lshl_b32 s71, s62, 12
    s_add_u32 s87, s71, 126976
    s_lshl_b32 s71, s12, 11
    v_add_u32 v8, s71, v32
    s_add_u32 m0, s71, 126976
    s_lshl_b32 s72, s62, 4
    s_add_u32 s72, s72, 143360
    v_mov_b32 v227, s72
    s_waitcnt lgkmcnt(0)
    s_mov_b32 s44, s24
    s_and_b32 s45, s25, 0xffff
    s_mov_b32 s46, 128
    s_mov_b32 s47, 0x00020000
    buffer_load_dword v225, v9, s[44:47], 0 offen
    s_mov_b32 s40, s22
    s_and_b32 s41, s23, 0xffff
    s_mov_b32 s42, 16384
    s_mov_b32 s43, 0x00020000
    buffer_load_dwordx4 v8, s[40:43], 0 offen offset:0 lds
    buffer_load_dwordx4 v8, s[40:43], 0 offen offset:1024 lds
    s_mov_b32 s48, s30
    s_and_b32 s49, s31, 0xffff
    s_mov_b32 s50, 1074790400
    s_mov_b32 s51, 0x00020000
    s_mov_b32 s52, s26
    s_and_b32 s53, s27, 0xffff
    s_mov_b32 s54, 262144
    s_mov_b32 s55, 0x00020000
    s_mov_b32 s56, s28
    s_and_b32 s57, s29, 0xffff
    s_mov_b32 s58, 256
    s_mov_b32 s59, 0x00020000
    s_mov_b32 s32, s18
    s_and_b32 s33, s19, 0xffff
    s_mov_b32 s34, 0
    s_mov_b32 s35, 0x00020000
    s_mov_b32 s36, s20
    s_and_b32 s37, s21, 0xffff
    s_mov_b32 s38, 0
    s_mov_b32 s39, 0x00020000
    v_mov_b32 v2, 0
    v_mov_b32 v3, 0
    ds_write_b64 v227, v[2:3]
    ds_write_b64 v227, v[2:3] offset:8
    v_and_b32 v4, 31, v1
    v_lshlrev_b32 v4, 2, v4
    v_add_u32 v4, 143424, v4
    ds_write_b32 v4, v2
    s_cmp_eq_u32 s7, 0
    s_cbranch_scc1 L_lpre
    s_waitcnt vmcnt(0) lgkmcnt(0)
    s_barrier
    s_branch L_pre_cons
L_lpre:
    v_lshrrev_b32 v2, 5, v1
    v_and_b32 v3, 31, v1
    s_lshl_b32 s71, s61, 9
    v_lshlrev_b32 v4, 12, v2
    v_add_u32 v4, s71, v4
    v_xor_b32 v5, v3, v2
    v_lshlrev_b32 v6, 1, v2
    v_xor_b32 v6, v3, v6
    v_xor_b32 v7, 0, v5
    v_lshl_add_u32 v7, v7, 4, v4
    v_add_u32 v16, 0, v7
    v_xor_b32 v7, 0, v6
    v_lshl_add_u32 v7, v7, 4, v4
    v_add_u32 v24, 0, v7
    v_xor_b32 v7, 2, v5
    v_lshl_add_u32 v7, v7, 4, v4
    v_add_u32 v17, 7168, v7
    v_xor_b32 v7, 4, v6
    v_lshl_add_u32 v7, v7, 4, v4
    v_add_u32 v25, 7168, v7
    v_xor_b32 v7, 4, v5
    v_lshl_add_u32 v7, v7, 4, v4
    v_add_u32 v18, 14336, v7
    v_xor_b32 v7, 8, v6
    v_lshl_add_u32 v7, v7, 4, v4
    v_add_u32 v26, 14336, v7
    v_xor_b32 v7, 6, v5
    v_lshl_add_u32 v7, v7, 4, v4
    v_add_u32 v19, 21504, v7
    v_xor_b32 v7, 12, v6
    v_lshl_add_u32 v7, v7, 4, v4
    v_add_u32 v27, 21504, v7
    v_xor_b32 v7, 8, v5
    v_lshl_add_u32 v7, v7, 4, v4
    v_add_u32 v20, 32768, v7
    v_xor_b32 v7, 0, v6
    v_lshl_add_u32 v7, v7, 4, v4
    v_add_u32 v28, 32768, v7
    v_xor_b32 v7, 10, v5
    v_lshl_add_u32 v7, v7, 4, v4
    v_add_u32 v21, 39936, v7
    v_xor_b32 v7, 4, v6
    v_lshl_add_u32 v7, v7, 4, v4
    v_add_u32 v29, 39936, v7
    v_xor_b32 v7, 12, v5
    v_lshl_add_u32 v7, v7, 4, v4
    v_add_u32 v22, 47104, v7
    v_xor_b32 v7, 8, v6
    v_lshl_add_u32 v7, v7, 4, v4
    v_add_u32 v30, 47104, v7
    v_xor_b32 v7, 14, v5
    v_lshl_add_u32 v7, v7, 4, v4
    v_add_u32 v23, 54272, v7
    v_xor_b32 v7, 12, v6
    v_lshl_add_u32 v7, v7, 4, v4
    v_add_u32 v31, 54272, v7
L_sched:
    v_cmp_gt_u32 vcc, 32, v1
    s_waitcnt vmcnt(2)
    v_cmp_gt_i32 s[90:91], 1, v225
    v_min_i32 v2, 0x800, v225
    v_mov_b32 v3, 0x800
    v_cndmask_b32 v225, v2, v3, s[90:91]
    v_cndmask_b32 v9, 0, 1, s[90:91]
    v_add_u32 v226, 15, v225
    v_lshrrev_b32 v226, 4, v226
    v_lshl_or_b32 v225, v9, 16, v225
    v_cndmask_b32 v226, 0, v226, vcc
    v_mov_b32 v2, v226
    s_nop 1
    v_add_u32_dpp v2, v2, v2 row_shr:1 row_mask:0xf bank_mask:0xf bound_ctrl:0
    s_nop 1
    v_add_u32_dpp v2, v2, v2 row_shr:2 row_mask:0xf bank_mask:0xf bound_ctrl:0
    s_nop 1
    v_add_u32_dpp v2, v2, v2 row_shr:4 row_mask:0xf bank_mask:0xf bound_ctrl:0
    s_nop 1
    v_add_u32_dpp v2, v2, v2 row_shr:8 row_mask:0xf bank_mask:0xf bound_ctrl:0
    s_nop 1
    v_add_u32_dpp v2, v2, v2 row_bcast:15 row_mask:0xa bank_mask:0xf
    s_nop 0
    v_readlane_b32 s71, v2, 31
    s_nop 3
    s_add_u32 s71, s71, 31
    s_lshr_b32 s63, s71, 5
    v_subrev_u32 v2, s63, v226
    v_max_i32 v3, 0, v2
    v_sub_u32 v2, 0, v2
    v_max_i32 v4, 0, v2
    v_cndmask_b32 v4, 0, v4, vcc
    v_lshl_or_b32 v5, v4, 16, v3
    s_nop 1
    v_add_u32_dpp v5, v5, v5 row_shr:1 row_mask:0xf bank_mask:0xf bound_ctrl:0
    s_nop 1
    v_add_u32_dpp v5, v5, v5 row_shr:2 row_mask:0xf bank_mask:0xf bound_ctrl:0
    s_nop 1
    v_add_u32_dpp v5, v5, v5 row_shr:4 row_mask:0xf bank_mask:0xf bound_ctrl:0
    s_nop 1
    v_add_u32_dpp v5, v5, v5 row_shr:8 row_mask:0xf bank_mask:0xf bound_ctrl:0
    s_nop 1
    v_add_u32_dpp v5, v5, v5 row_bcast:15 row_mask:0xa bank_mask:0xf
    v_and_b32 v15, 0xffff, v5
    v_lshrrev_b32 v13, 16, v5
    v_sub_u32 v14, v15, v3
    v_sub_u32 v12, v13, v4
    v_readlane_b32 s71, v15, 31
    v_readlane_b32 s80, v12, s60
    v_readlane_b32 s72, v4, s60
    v_readlane_b32 s73, v226, s60
    v_readlane_b32 s81, v14, s60
    v_readlane_b32 s82, v3, s60
    v_readlane_b32 s74, v225, s60
    v_mov_b32 v2, 0x7fffffff
    v_cndmask_b32 v15, v2, v15, vcc
    v_cndmask_b32 v13, v2, v13, vcc
    s_sub_i32 s71, s71, s80
    s_max_i32 s71, s71, 0
    s_min_i32 s79, s71, s72
    s_min_u32 s73, s73, s63
    s_add_u32 s73, s73, s79
    s_sub_i32 s71, s73, s62
    s_add_i32 s71, s71, 3
    s_ashr_i32 s65, s71, 2
    v_lshlrev_b32 v2, 2, v1
    v_add_u32 v2, s62, v2
    v_mov_b32 v3, s60
    v_subrev_u32 v4, s79, v2
    v_mov_b32 v5, s74
    v_add_u32 v6, s80, v2
    v_cmp_gt_u32 s[90:91], s79, v2
    s_mov_b32 s83, s80
    s_add_u32 s84, s80, s79
L_piece:
    s_cmp_ge_u32 s83, s84
    s_cbranch_scc1 L_piece_done
    v_cmp_ge_u32 vcc, s83, v15
    s_nop 3
    s_bcnt1_i32_b64 s71, vcc
    v_cmp_le_u32 vcc, s83, v6
    v_readlane_b32 s72, v14, s71
    v_readlane_b32 s83, v15, s71
    v_readlane_b32 s74, v225, s71
    s_nop 3
    s_and_b64 vcc, vcc, s[90:91]
    s_sub_i32 s72, s63, s72
    v_mov_b32 v7, s71
    v_add_u32 v8, s72, v6
    v_mov_b32 v9, s74
    v_cndmask_b32 v3, v3, v7, vcc
    v_cndmask_b32 v4, v4, v8, vcc
    v_cndmask_b32 v5, v5, v9, vcc
    s_branch L_piece
L_piece_done:
    v_cmp_gt_u32 vcc, s73, v2
    v_and_b32 v6, 0xffff, v5
    v_lshlrev_b32 v7, 4, v4
    v_sub_u32 v6, v6, v7
    v_min_i32 v6, 16, v6
    v_cndmask_b32 v6, 0, v6, vcc
    v_cndmask_b32 v4, 0, v4, vcc
    v_and_b32 v5, 0x10000, v5
    v_lshl_or_b32 v11, v6, 8, v3
    v_or_b32 v11, v11, v5
    v_lshl_add_u32 v7, v3, 7, v4
    v_lshlrev_b32 v7, 2, v7
    v_add_u32 v7, 126976, v7
    s_mov_b32 s40, s16
    s_and_b32 s41, s17, 0xffff
    s_mov_b32 s42, 262144
    s_mov_b32 s43, 0x00020000
    s_cmp_lg_u32 s7, 0
    s_cbranch_scc1 L_cons_main
    s_waitcnt vmcnt(0) lgkmcnt(0)
    s_barrier
L_loader:
    ds_read_b32 v10, v7
    s_mov_b32 s66, 0
    s_mov_b32 s85, 0
    s_lshl_b32 s5, s61, 10
    s_add_u32 s9, s64, 27648
    s_mov_b32 s8, s64
    s_mov_b32 s10, 0
    s_waitcnt lgkmcnt(0)
    v_readlane_b32 s69, v11, s66
    v_readlane_b32 s70, v10, s66
    s_add_u32 s66, s66, 1
    s_sub_i32 s11, s85, 2
    s_nop 1
    s_lshl_b32 s3, s70, 16
    s_lshr_b32 s4, s70, 16
    s_bfe_u32 s73, s69, 0x50008
    s_add_u32 s32, s18, s3
    s_addc_u32 s33, s19, s4
    s_lshl_b32 s34, s73, 12
    s_and_b32 s74, s69, 31
    s_lshl_b32 s74, s74, 13
    s_add_u32 s86, s74, s5
    s_mov_b32 m0, s8
    s_nop 0
    buffer_load_dwordx4 v32, s[40:43], s86 offen lds
    s_add_u32 m0, s8, 1024
    s_nop 0
    buffer_load_dwordx4 v16, s[32:35], 0 offen offset:0 nt lds
    buffer_load_dwordx4 v17, s[32:35], 0 offen offset:1024 nt lds
    buffer_load_dwordx4 v18, s[32:35], 0 offen offset:2048 nt lds
    buffer_load_dwordx4 v19, s[32:35], 0 offen offset:3072 nt lds
    s_add_u32 m0, s8, 5120
    s_nop 0
    buffer_load_dwordx4 v20, s[32:35], 0 offen offset:0 nt lds
    buffer_load_dwordx4 v21, s[32:35], 0 offen offset:1024 nt lds
    buffer_load_dwordx4 v22, s[32:35], 0 offen offset:2048 nt lds
    buffer_load_dwordx4 v23, s[32:35], 0 offen offset:3072 nt lds
    s_add_u32 s8, s8, 9216
    s_cmp_eq_u32 s8, s9
    s_cselect_b32 s8, s64, s8
    s_barrier
    s_cmp_eq_u32 s65, 0
    s_cbranch_scc1 L_ld_done
L_ld_k:
    s_waitcnt vmcnt(0)
    s_add_u32 s85, s85, 1
    v_mov_b32 v3, s85
    s_mov_b64 exec, 1
    ds_write_b32 v227, v3 offset:0
    s_mov_b64 exec, -1
    s_cmp_ge_u32 s85, s65
    s_cbranch_scc1 L_ld_v0
    v_readlane_b32 s69, v11, s66
    v_readlane_b32 s70, v10, s66
    s_add_u32 s66, s66, 1
    s_sub_i32 s11, s85, 2
    s_nop 1
    s_lshl_b32 s3, s70, 16
    s_lshr_b32 s4, s70, 16
    s_bfe_u32 s73, s69, 0x50008
    s_add_u32 s32, s18, s3
    s_addc_u32 s33, s19, s4
    s_lshl_b32 s34, s73, 12
    s_and_b32 s74, s69, 31
    s_lshl_b32 s74, s74, 13
    s_add_u32 s86, s74, s5
    s_cmp_ge_i32 s10, s11
    s_cbranch_scc1 L_wok1
L_wp1:
    ds_read_b32 v2, v227 offset:4
    s_waitcnt lgkmcnt(0)
    v_readfirstlane_b32 s10, v2
    s_nop 1
    s_cmp_ge_i32 s10, s11
    s_cbranch_scc1 L_wok1
    s_sleep 1
    s_branch L_wp1
L_wok1:
    s_mov_b32 m0, s8
    s_nop 0
    buffer_load_dwordx4 v32, s[40:43], s86 offen lds
    s_add_u32 m0, s8, 1024
    s_nop 0
    buffer_load_dwordx4 v16, s[32:35], 0 offen offset:0 nt lds
    buffer_load_dwordx4 v17, s[32:35], 0 offen offset:1024 nt lds
    buffer_load_dwordx4 v18, s[32:35], 0 offen offset:2048 nt lds
    buffer_load_dwordx4 v19, s[32:35], 0 offen offset:3072 nt lds
    s_add_u32 m0, s8, 5120
    s_nop 0
    buffer_load_dwordx4 v20, s[32:35], 0 offen offset:0 nt lds
    buffer_load_dwordx4 v21, s[32:35], 0 offen offset:1024 nt lds
    buffer_load_dwordx4 v22, s[32:35], 0 offen offset:2048 nt lds
    buffer_load_dwordx4 v23, s[32:35], 0 offen offset:3072 nt lds
    s_add_u32 s8, s8, 9216
    s_cmp_eq_u32 s8, s9
    s_cselect_b32 s8, s64, s8
    s_branch L_ld_k
L_ld_v0:
    s_mov_b32 s66, 0
    s_lshl_b32 s65, s65, 1
L_ld_v:
    v_readlane_b32 s69, v11, s66
    v_readlane_b32 s70, v10, s66
    s_add_u32 s66, s66, 1
    s_sub_i32 s11, s85, 2
    s_nop 1
    s_lshl_b32 s3, s70, 16
    s_lshr_b32 s4, s70, 16
    s_bfe_u32 s73, s69, 0x50008
    s_add_u32 s36, s20, s3
    s_addc_u32 s37, s21, s4
    s_lshl_b32 s38, s73, 12
    s_cmp_ge_i32 s10, s11
    s_cbranch_scc1 L_wok2
L_wp2:
    ds_read_b32 v2, v227 offset:4
    s_waitcnt lgkmcnt(0)
    v_readfirstlane_b32 s10, v2
    s_nop 1
    s_cmp_ge_i32 s10, s11
    s_cbranch_scc1 L_wok2
    s_sleep 1
    s_branch L_wp2
L_wok2:
    s_add_u32 m0, s8, 1024
    s_nop 0
    buffer_load_dwordx4 v24, s[36:39], 0 offen offset:0 nt lds
    buffer_load_dwordx4 v25, s[36:39], 0 offen offset:1024 nt lds
    buffer_load_dwordx4 v26, s[36:39], 0 offen offset:2048 nt lds
    buffer_load_dwordx4 v27, s[36:39], 0 offen offset:3072 nt lds
    s_add_u32 m0, s8, 5120
    s_nop 0
    buffer_load_dwordx4 v28, s[36:39], 0 offen offset:0 nt lds
    buffer_load_dwordx4 v29, s[36:39], 0 offen offset:1024 nt lds
    buffer_load_dwordx4 v30, s[36:39], 0 offen offset:2048 nt lds
    buffer_load_dwordx4 v31, s[36:39], 0 offen offset:3072 nt lds
    s_add_u32 s8, s8, 9216
    s_cmp_eq_u32 s8, s9
    s_cselect_b32 s8, s64, s8
    s_waitcnt vmcnt(0)
    s_add_u32 s85, s85, 1
    v_mov_b32 v3, s85
    s_mov_b64 exec, 1
    ds_write_b32 v227, v3 offset:0
    s_mov_b64 exec, -1
    s_cmp_lt_u32 s85, s65
    s_cbranch_scc1 L_ld_v
L_ld_done:
    s_endpgm
L_pre_cons:
    v_and_b32 v2, 15, v1
    v_lshrrev_b32 v3, 4, v1
    v_and_b32 v4, 1, v1
    v_lshlrev_b32 v4, 9, v4
    v_lshl_add_u32 v4, v3, 4, v4
    v_add_u32 v33, s64, v4
    v_xor_b32 v4, v3, v2
    v_lshlrev_b32 v5, 9, v2
    v_add_u32 v5, s64, v5
    v_add_u32 v5, 1024, v5
    v_xor_b32 v6, 0, v4
    v_lshl_add_u32 v34, v6, 4, v5
    v_xor_b32 v6, 4, v4
    v_lshl_add_u32 v35, v6, 4, v5
    v_xor_b32 v6, 8, v4
    v_lshl_add_u32 v36, v6, 4, v5
    v_xor_b32 v6, 12, v4
    v_lshl_add_u32 v37, v6, 4, v5
    v_lshrrev_b32 v2, 2, v1
    v_and_b32 v4, 3, v1
    v_and_b32 v5, 7, v2
    v_lshlrev_b32 v5, 1, v5
    v_lshrrev_b32 v6, 1, v4
    v_xor_b32 v5, v5, v6
    v_and_b32 v6, 1, v4
    v_lshlrev_b32 v6, 3, v6
    v_lshl_add_u32 v6, v2, 9, v6
    v_add_u32 v6, s64, v6
    v_add_u32 v6, 1024, v6
    v_xor_b32 v7, 0, v5
    v_lshl_add_u32 v38, v7, 4, v6
    v_xor_b32 v7, 2, v5
    v_lshl_add_u32 v39, v7, 4, v6
    v_xor_b32 v7, 4, v5
    v_lshl_add_u32 v40, v7, 4, v6
    v_xor_b32 v7, 6, v5
    v_lshl_add_u32 v41, v7, 4, v6
    v_xor_b32 v7, 8, v5
    v_lshl_add_u32 v42, v7, 4, v6
    v_xor_b32 v7, 10, v5
    v_lshl_add_u32 v43, v7, 4, v6
    v_xor_b32 v7, 12, v5
    v_lshl_add_u32 v44, v7, 4, v6
    v_xor_b32 v7, 14, v5
    v_lshl_add_u32 v45, v7, 4, v6
    v_lshlrev_b32 v46, 2, v3
    v_add_u32 v47, 1, v46
    v_add_u32 v48, 2, v46
    v_add_u32 v49, 3, v46
    s_branch L_sched
L_cons_main:
    v_mov_b32 v224, 0xff7fffff
    v_mov_b32 v50, 0xff800000
    v_mov_b32 v51, 0
    v_mov_b32 v160, 0
    v_mov_b32 v161, 0
    v_mov_b32 v162, 0
    v_mov_b32 v163, 0
    v_mov_b32 v164, 0
    v_mov_b32 v165, 0
    v_mov_b32 v166, 0
    v_mov_b32 v167, 0
    v_mov_b32 v168, 0
    v_mov_b32 v169, 0
    v_mov_b32 v170, 0
    v_mov_b32 v171, 0
    v_mov_b32 v172, 0
    v_mov_b32 v173, 0
    v_mov_b32 v174, 0
    v_mov_b32 v175, 0
    v_mov_b32 v176, 0
    v_mov_b32 v177, 0
    v_mov_b32 v178, 0
    v_mov_b32 v179, 0
    v_mov_b32 v180, 0
    v_mov_b32 v181, 0
    v_mov_b32 v182, 0
    v_mov_b32 v183, 0
    v_mov_b32 v184, 0
    v_mov_b32 v185, 0
    v_mov_b32 v186, 0
    v_mov_b32 v187, 0
    v_mov_b32 v188, 0
    v_mov_b32 v189, 0
    v_mov_b32 v190, 0
    v_mov_b32 v191, 0
    v_mov_b32 v192, 0
    v_mov_b32 v193, 0
    v_mov_b32 v194, 0
    v_mov_b32 v195, 0
    v_mov_b32 v196, 0
    v_mov_b32 v197, 0
    v_mov_b32 v198, 0
    v_mov_b32 v199, 0
    v_mov_b32 v200, 0
    v_mov_b32 v201, 0
    v_mov_b32 v202, 0
    v_mov_b32 v203, 0
    v_mov_b32 v204, 0
    v_mov_b32 v205, 0
    v_mov_b32 v206, 0
    v_mov_b32 v207, 0
    v_mov_b32 v208, 0
    v_mov_b32 v209, 0
    v_mov_b32 v210, 0
    v_mov_b32 v211, 0
    v_mov_b32 v212, 0
    v_mov_b32 v213, 0
    v_mov_b32 v214, 0
    v_mov_b32 v215, 0
    v_mov_b32 v216, 0
    v_mov_b32 v217, 0
    v_mov_b32 v218, 0
    v_mov_b32 v219, 0
    v_mov_b32 v220, 0
    v_mov_b32 v221, 0
    v_mov_b32 v222, 0
    v_mov_b32 v223, 0
    s_mov_b32 s92, 0x3db8aa3b
    s_mov_b32 s75, 0
    s_mov_b32 s85, 0
    s_mov_b32 s10, 0
    s_mov_b32 s14, 0
    s_mov_b32 s8, 0
    s_mov_b32 s98, 0x00030003
    s_mov_b32 s99, 0x00030003
    v_lshrrev_b32 v2, 4, v1
    v_and_b32 v3, 1, v1
    v_lshl_add_u32 v2, v2, 1, v3
    v_lshlrev_b32 v2, 4, v2
    v_add_u32 v2, s64, v2
    v_add_u32 v226, 27648, v2
    v_mov_b32 v225, v226
    s_mov_b32 s15, 0
    s_mov_b32 s97, 0
    s_add_u32 s71, s2, s62
    s_cmp_lg_u32 s71, 0
    s_cbranch_scc1 L_nononce
    s_memrealtime s[90:91]
    v_mov_b32 v2, 0
    s_waitcnt lgkmcnt(0)
    s_or_b32 s71, s90, 1
    v_mov_b32 v4, s71
    v_mov_b32 v5, s91
    s_mov_b64 exec, 1
    buffer_store_dwordx2 v[4:5], v2, s[56:59], 0 offen sc1
    s_mov_b64 exec, -1
L_nononce:
    v_and_b32 v0, 255, v0
    v_lshrrev_b32 v7, 7, v0
    v_and_b32 v8, 127, v0
    v_lshrrev_b32 v9, 3, v8
    v_and_b32 v8, 7, v8
    v_lshlrev_b32 v8, 3, v8
    v_lshl_add_u32 v8, v9, 7, v8
    v_lshl_add_u32 v232, v7, 6, v8
    v_lshlrev_b32 v7, 3, v7
    v_add_u32 v233, 0x800, v7
    v_lshlrev_b32 v7, 2, v7
    v_add_u32 v235, 0x800, v7
    v_mov_b32 v228, 0xff800000
    v_mov_b32 v229, 0
    v_mov_b32 v230, 0
    v_mov_b32 v231, 0
    s_add_u32 s84, s81, s82
    v_min_u32 v2, s84, v13
    v_max_u32 v3, s81, v12
    v_sub_u32 v2, v2, v3
    v_cmp_gt_u32 vcc, 32, v1
    v_lshlrev_b32 v234, 3, v1
    v_add_u32 v234, s61, v234
    v_lshlrev_b32 v234, 7, v234
    v_cndmask_b32 v2, 0, v2, vcc
    v_cmp_lt_i32 s[88:89], 0, v2
    s_add_u32 s77, s80, s79
    v_min_u32 v2, s77, v15
    v_max_u32 v3, s80, v14
    v_sub_u32 v2, v2, v3
    v_cndmask_b32 v2, 0, v2, vcc
    v_cmp_lt_i32 vcc, 0, v2
    s_nop 3
    s_bcnt1_i32_b64 s76, vcc
    s_cmp_eq_u32 s82, 0
    s_cselect_b32 s13, 1, 0
    s_barrier
    s_cmp_eq_u32 s65, 0
    s_cbranch_scc1 L_done
L_p1:
    v_readlane_b32 s67, v11, s85
    s_add_u32 s11, s85, 1
    v_add_u32 v128, s8, v33
    v_add_u32 v129, s8, v34
    v_add_u32 v130, s8, v35
    v_add_u32 v131, s8, v36
    v_add_u32 v132, s8, v37
    s_cmp_ge_i32 s10, s11
    s_cbranch_scc1 L_wok3
L_wp3:
    ds_read_b32 v2, v227 offset:0
    s_waitcnt lgkmcnt(0)
    v_readfirstlane_b32 s10, v2
    s_nop 1
    s_cmp_ge_i32 s10, s11
    s_cbranch_scc1 L_wok3
    s_sleep 1
    s_branch L_wp3
L_wok3:
    ds_read_b128 v[64:67], v128 offset:0
    ds_read_b128 v[96:99], v129 offset:0
    ds_read_b128 v[68:71], v128 offset:64
    ds_read_b128 v[100:103], v130 offset:0
    ds_read_b128 v[72:75], v128 offset:128
    ds_read_b128 v[104:107], v131 offset:0
    ds_read_b128 v[76:79], v128 offset:192
    ds_read_b128 v[108:111], v132 offset:0
    ds_read_b128 v[80:83], v128 offset:256
    ds_read_b128 v[112:115], v129 offset:256
    ds_read_b128 v[84:87], v128 offset:320
    ds_read_b128 v[116:119], v130 offset:256
    ds_read_b128 v[88:91], v128 offset:384
    ds_read_b128 v[120:123], v131 offset:256
    ds_read_b128 v[92:95], v128 offset:448
    ds_read_b128 v[124:127], v132 offset:256
    s_bfe_u32 s6, s67, 0x50008
    s_waitcnt lgkmcnt(14)
    v_mfma_f32_16x16x32_bf16 v[52:55], v[96:99], v[64:67], 0
    s_waitcnt lgkmcnt(12)
    v_mfma_f32_16x16x32_bf16 v[52:55], v[100:103], v[68:71], v[52:55]
    s_waitcnt lgkmcnt(10)
    v_mfma_f32_16x16x32_bf16 v[52:55], v[104:107], v[72:75], v[52:55]
    s_waitcnt lgkmcnt(8)
    v_mfma_f32_16x16x32_bf16 v[52:55], v[108:111], v[76:79], v[52:55]
    s_waitcnt lgkmcnt(6)
    v_mfma_f32_16x16x32_bf16 v[52:55], v[112:115], v[80:83], v[52:55]
    s_waitcnt lgkmcnt(4)
    v_mfma_f32_16x16x32_bf16 v[52:55], v[116:119], v[84:87], v[52:55]
    s_waitcnt lgkmcnt(2)
    v_mfma_f32_16x16x32_bf16 v[52:55], v[120:123], v[88:91], v[52:55]
    s_waitcnt lgkmcnt(0)
    v_mfma_f32_16x16x32_bf16 v[52:55], v[124:127], v[92:95], v[52:55]
    v_mov_b32 v3, s11
    s_mov_b64 exec, 1
    ds_write_b32 v227, v3 offset:4
    s_mov_b64 exec, -1
    s_add_u32 s8, s8, 9216
    s_cmp_eq_u32 s8, 27648
    s_cselect_b32 s8, 0, s8
    s_cmp_eq_u32 s6, 16
    s_nop 1
    s_cbranch_scc1 L_full
    v_cmp_gt_u32 vcc, s6, v46
    s_nop 1
    v_cndmask_b32 v52, v224, v52, vcc
    v_cmp_gt_u32 vcc, s6, v47
    s_nop 1
    v_cndmask_b32 v53, v224, v53, vcc
    v_cmp_gt_u32 vcc, s6, v48
    s_nop 1
    v_cndmask_b32 v54, v224, v54, vcc
    v_cmp_gt_u32 vcc, s6, v49
    s_nop 1
    v_cndmask_b32 v55, v224, v55, vcc
L_full:
    s_mov_b64 exec, s[98:99]
    ds_write_b128 v225, v[52:55]
    s_mov_b64 exec, -1
    v_add_u32 v225, 0x80, v225
    s_add_u32 s85, s85, 1
    s_cmp_lt_u32 s85, s65
    s_cbranch_scc1 L_p1
    s_mov_b32 s85, 0
    v_mov_b32 v225, v226
L_loop:
    s_cmp_eq_u32 s13, 1
    s_cbranch_scc1 L_loop_go
    s_add_u32 s71, s85, 6
    s_cmp_ge_u32 s71, s65
    s_cbranch_scc1 L_rectry
L_loop_go:
    ds_read_b128 v[52:55], v225
    s_add_u32 s71, s85, 1
    v_readlane_b32 s67, v11, s85
    v_readlane_b32 s68, v11, s71
    s_add_u32 s11, s71, s65
    v_add_u32 v225, 0x80, v225
    v_add_u32 v96, s8, v38
    v_add_u32 v97, s8, v39
    v_add_u32 v98, s8, v40
    v_add_u32 v99, s8, v41
    v_add_u32 v100, s8, v42
    v_add_u32 v101, s8, v43
    v_add_u32 v102, s8, v44
    v_add_u32 v103, s8, v45
    s_bitcmp1_b32 s67, 16
    s_cselect_b32 s78, 0, s92
    s_cmp_eq_u32 s75, 0
    s_cbranch_scc1 L_nopend_a
    s_waitcnt vmcnt(0)
    v_mov_b32 v2, 143368
    v_mov_b32 v3, 1
    s_mov_b64 exec, 1
    ds_add_rtn_u32 v4, v2, v3
    v_mov_b32 v2, 0
    s_waitcnt lgkmcnt(0)
    v_readfirstlane_b32 s71, v4
    s_nop 1
    s_add_u32 s71, s71, 1
    s_cmp_lg_u32 s71, s76
    s_cbranch_scc1 L_ff4
    s_mov_b32 s97, 0
    s_mov_b64 exec, 0xffff
    v_mov_b32 v2, 0
    v_lshlrev_b32 v3, 3, v1
    s_lshl_b32 s72, s2, 7
    s_add_u32 s72, s72, 268435456
    s_branch L_fw4
L_fn4:
    buffer_load_dwordx2 v[246:247], v2, s[56:59], 0 offen sc1
    s_waitcnt vmcnt(0)
L_fw4:
    v_readfirstlane_b32 s71, v246
    s_nop 1
    s_cmp_lg_u32 s71, 0
    s_cbranch_scc1 L_fs4
    s_sleep 8
    s_add_u32 s97, s97, 1
    s_cmp_lt_u32 s97, 0x200000
    s_cbranch_scc1 L_fn4
L_fs4:
    buffer_store_dwordx2 v[246:247], v3, s[48:51], s72 offen sc1
L_ff4:
    s_mov_b64 exec, -1
    s_mov_b32 s75, 0
L_nopend_a:
    s_waitcnt lgkmcnt(0)
    v_max3_f32 v58, v52, v53, v54
    v_max_f32 v58, v58, v55
    v_mul_f32 v58, s78, v58
    v_cmp_gt_f32 vcc, v58, v50
    s_nop 1
    s_cbranch_vccnz L_rare_a
L_back_a:
    v_fma_f32 v58, v52, s78, -v50
    v_fma_f32 v59, v53, s78, -v50
    v_fma_f32 v60, v54, s78, -v50
    v_fma_f32 v61, v55, s78, -v50
    v_exp_f32 v58, v58
    v_exp_f32 v59, v59
    v_exp_f32 v60, v60
    v_exp_f32 v61, v61
    s_nop 0
    v_cvt_pk_bf16_f32 v56, v58, v59
    v_cvt_pk_bf16_f32 v57, v60, v61
    v_add_f32 v58, v58, v59
    v_add_f32 v60, v60, v61
    v_add_f32 v51, v51, v58
    v_add_f32 v51, v51, v60
    s_cmp_ge_i32 s10, s11
    s_cbranch_scc1 L_wok5
L_wp5:
    ds_read_b32 v2, v227 offset:0
    s_waitcnt lgkmcnt(0)
    v_readfirstlane_b32 s10, v2
    s_nop 1
    s_cmp_ge_i32 s10, s11
    s_cbranch_scc1 L_wok5
    s_sleep 1
    s_branch L_wp5
L_wok5:
    ds_read_b64_tr_b16 v[128:129], v96 offset:0
    ds_read_b64_tr_b16 v[130:131], v97 offset:0
    ds_read_b64_tr_b16 v[132:133], v98 offset:0
    ds_read_b64_tr_b16 v[134:135], v99 offset:0
    ds_read_b64_tr_b16 v[136:137], v100 offset:0
    ds_read_b64_tr_b16 v[138:139], v101 offset:0
    ds_read_b64_tr_b16 v[140:141], v102 offset:0
    ds_read_b64_tr_b16 v[142:143], v103 offset:0
    ds_read_b64_tr_b16 v[144:145], v96 offset:256
    ds_read_b64_tr_b16 v[146:147], v97 offset:256
    ds_read_b64_tr_b16 v[148:149], v98 offset:256
    ds_read_b64_tr_b16 v[150:151], v99 offset:256
    ds_read_b64_tr_b16 v[152:153], v100 offset:256
    ds_read_b64_tr_b16 v[154:155], v101 offset:256
    ds_read_b64_tr_b16 v[156:157], v102 offset:256
    ds_read_b64_tr_b16 v[158:159], v103 offset:256
    s_waitcnt lgkmcnt(15)
    v_mfma_f32_16x16x16_bf16 v[160:163], v[56:57], v[128:129], v[160:163]
    s_waitcnt lgkmcnt(14)
    v_mfma_f32_16x16x16_bf16 v[164:167], v[56:57], v[130:131], v[164:167]
    s_waitcnt lgkmcnt(13)
    v_mfma_f32_16x16x16_bf16 v[168:171], v[56:57], v[132:133], v[168:171]
    s_waitcnt lgkmcnt(12)
    v_mfma_f32_16x16x16_bf16 v[172:175], v[56:57], v[134:135], v[172:175]
    s_waitcnt lgkmcnt(11)
    v_mfma_f32_16x16x16_bf16 v[176:179], v[56:57], v[136:137], v[176:179]
    s_waitcnt lgkmcnt(10)
    v_mfma_f32_16x16x16_bf16 v[180:183], v[56:57], v[138:139], v[180:183]
    s_waitcnt lgkmcnt(9)
    v_mfma_f32_16x16x16_bf16 v[184:187], v[56:57], v[140:141], v[184:187]
    s_waitcnt lgkmcnt(8)
    v_mfma_f32_16x16x16_bf16 v[188:191], v[56:57], v[142:143], v[188:191]
    s_waitcnt lgkmcnt(7)
    v_mfma_f32_16x16x16_bf16 v[192:195], v[56:57], v[144:145], v[192:195]
    s_waitcnt lgkmcnt(6)
    v_mfma_f32_16x16x16_bf16 v[196:199], v[56:57], v[146:147], v[196:199]
    s_waitcnt lgkmcnt(5)
    v_mfma_f32_16x16x16_bf16 v[200:203], v[56:57], v[148:149], v[200:203]
    s_waitcnt lgkmcnt(4)
    v_mfma_f32_16x16x16_bf16 v[204:207], v[56:57], v[150:151], v[204:207]
    s_waitcnt lgkmcnt(3)
    v_mfma_f32_16x16x16_bf16 v[208:211], v[56:57], v[152:153], v[208:211]
    s_waitcnt lgkmcnt(2)
    v_mfma_f32_16x16x16_bf16 v[212:215], v[56:57], v[154:155], v[212:215]
    s_waitcnt lgkmcnt(1)
    v_mfma_f32_16x16x16_bf16 v[216:219], v[56:57], v[156:157], v[216:219]
    s_waitcnt lgkmcnt(0)
    v_mfma_f32_16x16x16_bf16 v[220:223], v[56:57], v[158:159], v[220:223]
    v_mov_b32 v3, s11
    s_mov_b64 exec, 1
    ds_write_b32 v227, v3 offset:4
    s_mov_b64 exec, -1
    s_add_u32 s8, s8, 9216
    s_cmp_eq_u32 s8, 27648
    s_cselect_b32 s8, 0, s8
    s_xor_b32 s71, s67, s68
    s_and_b32 s71, s71, 31
    s_cbranch_scc1 L_flush_a
L_noflush_a:
    s_add_u32 s85, s85, 1
    s_cmp_lt_u32 s85, s65
    s_cbranch_scc1 L_loop
L_done:
    s_cmp_eq_u32 s75, 0
    s_cbranch_scc1 L_fin0
    s_waitcnt vmcnt(0)
    v_mov_b32 v2, 143368
    v_mov_b32 v3, 1
    s_mov_b64 exec, 1
    ds_add_rtn_u32 v4, v2, v3
    v_mov_b32 v2, 0
    s_waitcnt lgkmcnt(0)
    v_readfirstlane_b32 s71, v4
    s_nop 1
    s_add_u32 s71, s71, 1
    s_cmp_lg_u32 s71, s76
    s_cbranch_scc1 L_ff6
    s_mov_b32 s97, 0
    s_mov_b64 exec, 0xffff
    v_mov_b32 v2, 0
    v_lshlrev_b32 v3, 3, v1
    s_lshl_b32 s72, s2, 7
    s_add_u32 s72, s72, 268435456
    s_branch L_fw6
L_fn6:
    buffer_load_dwordx2 v[246:247], v2, s[56:59], 0 offen sc1
    s_waitcnt vmcnt(0)
L_fw6:
    v_readfirstlane_b32 s71, v246
    s_nop 1
    s_cmp_lg_u32 s71, 0
    s_cbranch_scc1 L_fs6
    s_sleep 8
    s_add_u32 s97, s97, 1
    s_cmp_lt_u32 s97, 0x200000
    s_cbranch_scc1 L_fn6
L_fs6:
    buffer_store_dwordx2 v[246:247], v3, s[48:51], s72 offen sc1
L_ff6:
    s_mov_b64 exec, -1
    s_mov_b32 s75, 0
L_fin0:
    s_nop 7
L_bw7:
    ds_read_b32 v2, v227 offset:12
    s_waitcnt lgkmcnt(0)
    v_readfirstlane_b32 s71, v2
    s_nop 1
    s_cmp_eq_u32 s71, 0
    s_cbranch_scc1 L_bo7
    s_sleep 1
    s_branch L_bw7
L_bo7:
    v_mov_b32 v2, v51
    v_mov_b32 v3, v51
    s_nop 1
    v_permlane32_swap_b32 v2, v3
    s_nop 1
    v_add_f32 v51, v2, v3
    v_mov_b32 v2, v51
    s_nop 0
    v_mov_b32 v3, v51
    s_nop 1
    v_permlane16_swap_b32 v2, v3
    s_nop 1
    v_add_f32 v51, v2, v3
    v_lshlrev_b32 v4, 2, v1
    v_add_u32 v4, s87, v4
    v_add_u32 v5, 0x400, v4
    v_lshlrev_b32 v6, 3, v1
    v_add_u32 v6, s87, v6
    s_mov_b64 exec, 0xffff
    ds_write2_b32 v4, v160, v161 offset0:0 offset1:16
    ds_write2_b32 v4, v164, v165 offset0:32 offset1:48
    ds_write2_b32 v4, v168, v169 offset0:64 offset1:80
    ds_write2_b32 v4, v172, v173 offset0:96 offset1:112
    ds_write2_b32 v4, v176, v177 offset0:128 offset1:144
    ds_write2_b32 v4, v180, v181 offset0:160 offset1:176
    ds_write2_b32 v4, v184, v185 offset0:192 offset1:208
    ds_write2_b32 v4, v188, v189 offset0:224 offset1:240
    ds_write2_b32 v5, v192, v193 offset0:0 offset1:16
    ds_write2_b32 v5, v196, v197 offset0:32 offset1:48
    ds_write2_b32 v5, v200, v201 offset0:64 offset1:80
    ds_write2_b32 v5, v204, v205 offset0:96 offset1:112
    ds_write2_b32 v5, v208, v209 offset0:128 offset1:144
    ds_write2_b32 v5, v212, v213 offset0:160 offset1:176
    ds_write2_b32 v5, v216, v217 offset0:192 offset1:208
    ds_write2_b32 v5, v220, v221 offset0:224 offset1:240
    s_mov_b64 exec, 3
    ds_write_b64 v6, v[50:51] offset:2048
    s_mov_b64 exec, -1
    v_add_u32 v5, 126976, v232
    v_add_u32 v6, 126976, v233
    s_waitcnt lgkmcnt(0)
    s_barrier
    ds_read_b64 v[64:65], v6 offset:0
    ds_read_b64 v[66:67], v5 offset:0
    ds_read_b64 v[68:69], v6 offset:4096
    ds_read_b64 v[70:71], v5 offset:4096
    ds_read_b64 v[72:73], v6 offset:8192
    ds_read_b64 v[74:75], v5 offset:8192
    ds_read_b64 v[76:77], v6 offset:12288
    ds_read_b64 v[78:79], v5 offset:12288
    s_waitcnt lgkmcnt(0)
    v_max3_f32 v2, v64, v68, v72
    v_max3_f32 v2, v2, v76, v228
    v_sub_f32 v3, v228, v2
    v_sub_f32 v64, v64, v2
    v_sub_f32 v68, v68, v2
    v_sub_f32 v72, v72, v2
    v_sub_f32 v76, v76, v2
    v_exp_f32 v3, v3
    v_exp_f32 v64, v64
    v_exp_f32 v68, v68
    v_exp_f32 v72, v72
    v_exp_f32 v76, v76
    v_mov_b32 v228, v2
    v_mul_f32 v229, v229, v3
    v_mul_f32 v230, v230, v3
    v_mul_f32 v231, v231, v3
    v_fmac_f32 v229, v65, v64
    v_fmac_f32 v230, v66, v64
    v_fmac_f32 v231, v67, v64
    v_fmac_f32 v229, v69, v68
    v_fmac_f32 v230, v70, v68
    v_fmac_f32 v231, v71, v68
    v_fmac_f32 v229, v73, v72
    v_fmac_f32 v230, v74, v72
    v_fmac_f32 v231, v75, v72
    v_fmac_f32 v229, v77, v76
    v_fmac_f32 v230, v78, v76
    v_fmac_f32 v231, v79, v76
    s_mov_b32 s14, 1
    s_cmp_lg_u32 s13, 1
    s_cbranch_scc1 L_rectry
L_store:
    v_rcp_f32 v2, v229
    s_lshl_b32 s71, s2, 10
    v_lshlrev_b32 v3, 2, v0
    v_mul_f32 v230, v230, v2
    v_mul_f32 v231, v231, v2
    v_cvt_pk_bf16_f32 v4, v230, v231
    buffer_store_dword v4, v3, s[52:55], s71 offen
L_end:
    s_endpgm
L_rare_a:
    v_max_f32 v58, v58, v50
    v_mov_b32 v59, v58
    v_mov_b32 v60, v58
    s_nop 1
    v_permlane32_swap_b32 v59, v60
    s_nop 1
    v_max_f32 v58, v59, v60
    v_mov_b32 v59, v58
    s_nop 0
    v_mov_b32 v60, v58
    s_nop 1
    v_permlane16_swap_b32 v59, v60
    s_nop 1
    v_max_f32 v58, v59, v60
    v_sub_f32 v59, v50, v58
    v_exp_f32 v59, v59
    v_mov_b32 v50, v58
    s_nop 0
    v_mul_f32 v51, v51, v59
    v_mov_b32_dpp v62, v59 quad_perm:[0,0,0,0] row_mask:0xf bank_mask:0xf
    v_mov_b32_dpp v63, v59 quad_perm:[1,1,1,1] row_mask:0xf bank_mask:0xf
    v_mul_f32 v160, v62, v160
    v_mul_f32 v161, v63, v161
    v_mul_f32 v164, v62, v164
    v_mul_f32 v165, v63, v165
    v_mul_f32 v168, v62, v168
    v_mul_f32 v169, v63, v169
    v_mul_f32 v172, v62, v172
    v_mul_f32 v173, v63, v173
    v_mul_f32 v176, v62, v176
    v_mul_f32 v177, v63, v177
    v_mul_f32 v180, v62, v180
    v_mul_f32 v181, v63, v181
    v_mul_f32 v184, v62, v184
    v_mul_f32 v185, v63, v185
    v_mul_f32 v188, v62, v188
    v_mul_f32 v189, v63, v189
    v_mul_f32 v192, v62, v192
    v_mul_f32 v193, v63, v193
    v_mul_f32 v196, v62, v196
    v_mul_f32 v197, v63, v197
    v_mul_f32 v200, v62, v200
    v_mul_f32 v201, v63, v201
    v_mul_f32 v204, v62, v204
    v_mul_f32 v205, v63, v205
    v_mul_f32 v208, v62, v208
    v_mul_f32 v209, v63, v209
    v_mul_f32 v212, v62, v212
    v_mul_f32 v213, v63, v213
    v_mul_f32 v216, v62, v216
    v_mul_f32 v217, v63, v217
    v_mul_f32 v220, v62, v220
    v_mul_f32 v221, v63, v221
    s_branch L_back_a
L_flush_a:
    s_cmp_eq_u32 s75, 0
    s_cbranch_scc1 L_fl_np_a
    s_waitcnt vmcnt(0)
    v_mov_b32 v2, 143368
    v_mov_b32 v3, 1
    s_mov_b64 exec, 1
    ds_add_rtn_u32 v4, v2, v3
    v_mov_b32 v2, 0
    s_waitcnt lgkmcnt(0)
    v_readfirstlane_b32 s71, v4
    s_nop 1
    s_add_u32 s71, s71, 1
    s_cmp_lg_u32 s71, s76
    s_cbranch_scc1 L_ff8
    s_mov_b32 s97, 0
    s_mov_b64 exec, 0xffff
    v_mov_b32 v2, 0
    v_lshlrev_b32 v3, 3, v1
    s_lshl_b32 s72, s2, 7
    s_add_u32 s72, s72, 268435456
    s_branch L_fw8
L_fn8:
    buffer_load_dwordx2 v[246:247], v2, s[56:59], 0 offen sc1
    s_waitcnt vmcnt(0)
L_fw8:
    v_readfirstlane_b32 s71, v246
    s_nop 1
    s_cmp_lg_u32 s71, 0
    s_cbranch_scc1 L_fs8
    s_sleep 8
    s_add_u32 s97, s97, 1
    s_cmp_lt_u32 s97, 0x200000
    s_cbranch_scc1 L_fn8
L_fs8:
    buffer_store_dwordx2 v[246:247], v3, s[48:51], s72 offen sc1
L_ff8:
    s_mov_b64 exec, -1
    s_mov_b32 s75, 0
L_fl_np_a:
    s_nop 7
L_bw9:
    ds_read_b32 v2, v227 offset:12
    s_waitcnt lgkmcnt(0)
    v_readfirstlane_b32 s71, v2
    s_nop 1
    s_cmp_eq_u32 s71, 0
    s_cbranch_scc1 L_bo9
    s_sleep 1
    s_branch L_bw9
L_bo9:
    v_mov_b32 v2, v51
    v_mov_b32 v3, v51
    s_nop 1
    v_permlane32_swap_b32 v2, v3
    s_nop 1
    v_add_f32 v51, v2, v3
    v_mov_b32 v2, v51
    s_nop 0
    v_mov_b32 v3, v51
    s_nop 1
    v_permlane16_swap_b32 v2, v3
    s_nop 1
    v_add_f32 v51, v2, v3
    v_lshlrev_b32 v4, 2, v1
    v_add_u32 v4, s87, v4
    v_add_u32 v5, 0x400, v4
    v_lshlrev_b32 v6, 3, v1
    v_add_u32 v6, s87, v6
    s_mov_b64 exec, 0xffff
    ds_write2_b32 v4, v160, v161 offset0:0 offset1:16
    ds_write2_b32 v4, v164, v165 offset0:32 offset1:48
    ds_write2_b32 v4, v168, v169 offset0:64 offset1:80
    ds_write2_b32 v4, v172, v173 offset0:96 offset1:112
    ds_write2_b32 v4, v176, v177 offset0:128 offset1:144
    ds_write2_b32 v4, v180, v181 offset0:160 offset1:176
    ds_write2_b32 v4, v184, v185 offset0:192 offset1:208
    ds_write2_b32 v4, v188, v189 offset0:224 offset1:240
    ds_write2_b32 v5, v192, v193 offset0:0 offset1:16
    ds_write2_b32 v5, v196, v197 offset0:32 offset1:48
    ds_write2_b32 v5, v200, v201 offset0:64 offset1:80
    ds_write2_b32 v5, v204, v205 offset0:96 offset1:112
    ds_write2_b32 v5, v208, v209 offset0:128 offset1:144
    ds_write2_b32 v5, v212, v213 offset0:160 offset1:176
    ds_write2_b32 v5, v216, v217 offset0:192 offset1:208
    ds_write2_b32 v5, v220, v221 offset0:224 offset1:240
    s_mov_b64 exec, 3
    ds_write_b64 v6, v[50:51] offset:2048
    s_mov_b64 exec, -1
    s_and_b32 s96, s67, 31
    v_mov_b32 v3, 1
    s_lshl_b32 s71, s96, 2
    s_add_u32 s71, s71, 143424
    v_mov_b32 v2, s71
    v_readlane_b32 s72, v14, s96
    v_readlane_b32 s73, v15, s96
    s_mov_b64 exec, 1
    ds_write_b32 v227, v3 offset:12
    s_waitcnt lgkmcnt(0)
    ds_add_rtn_u32 v4, v2, v3
    s_mov_b64 exec, -1
    s_max_u32 s72, s72, s80
    s_min_u32 s73, s73, s77
    s_sub_u32 s95, s73, s72
    s_sub_u32 s94, s72, s80
    s_min_u32 s74, s95, 4
    v_mov_b32 v50, 0xff800000
    s_waitcnt lgkmcnt(0)
    v_readfirstlane_b32 s71, v4
    s_nop 1
    s_add_u32 s71, s71, 1
    s_cmp_lg_u32 s71, s74
    s_cbranch_scc1 L_noflush_a
    v_lshrrev_b32 v5, 2, v1
    v_and_b32 v5, 1, v5
    v_lshlrev_b32 v5, 3, v5
    v_add_u32 v5, 129024, v5
    v_add_u32 v6, 126976, v32
    v_mov_b32 v244, 0xff800000
    v_mov_b32 v245, 0
    v_mov_b32 v236, 0
    v_mov_b32 v237, 0
    v_mov_b32 v238, 0
    v_mov_b32 v239, 0
    v_mov_b32 v240, 0
    v_mov_b32 v241, 0
    v_mov_b32 v242, 0
    v_mov_b32 v243, 0
    v_mov_b32 v7, 143360
    v_mov_b32 v8, 0
    s_sub_u32 s71, 0, s94
    s_and_b32 s71, s71, 3
    s_cmp_ge_u32 s71, s95
    s_cbranch_scc1 L_fm0_a
    ds_read_b64 v[24:25], v5 offset:0
    ds_read_b128 v[16:19], v6 offset:0
    ds_read_b128 v[20:23], v6 offset:1024
    s_waitcnt lgkmcnt(0)
    s_mov_b64 exec, 1
    ds_write_b32 v7, v8 offset:12
    s_mov_b64 exec, -1
    v_max_f32 v2, v244, v24
    v_sub_f32 v3, v244, v2
    v_sub_f32 v4, v24, v2
    v_exp_f32 v3, v3
    v_exp_f32 v4, v4
    v_mov_b32 v244, v2
    v_mul_f32 v245, v245, v3
    v_fmac_f32 v245, v25, v4
    v_mul_f32 v236, v236, v3
    v_fmac_f32 v236, v16, v4
    v_mul_f32 v237, v237, v3
    v_fmac_f32 v237, v17, v4
    v_mul_f32 v238, v238, v3
    v_fmac_f32 v238, v18, v4
    v_mul_f32 v239, v239, v3
    v_fmac_f32 v239, v19, v4
    v_mul_f32 v240, v240, v3
    v_fmac_f32 v240, v20, v4
    v_mul_f32 v241, v241, v3
    v_fmac_f32 v241, v21, v4
    v_mul_f32 v242, v242, v3
    v_fmac_f32 v242, v22, v4
    v_mul_f32 v243, v243, v3
    v_fmac_f32 v243, v23, v4
L_fm0_a:
    s_sub_u32 s71, 1, s94
    s_and_b32 s71, s71, 3
    s_cmp_ge_u32 s71, s95
    s_cbranch_scc1 L_fm1_a
    ds_read_b64 v[24:25], v5 offset:4096
    ds_read_b128 v[16:19], v6 offset:4096
    ds_read_b128 v[20:23], v6 offset:5120
    s_waitcnt lgkmcnt(0)
    s_mov_b64 exec, 1
    ds_write_b32 v7, v8 offset:28
    s_mov_b64 exec, -1
    v_max_f32 v2, v244, v24
    v_sub_f32 v3, v244, v2
    v_sub_f32 v4, v24, v2
    v_exp_f32 v3, v3
    v_exp_f32 v4, v4
    v_mov_b32 v244, v2
    v_mul_f32 v245, v245, v3
    v_fmac_f32 v245, v25, v4
    v_mul_f32 v236, v236, v3
    v_fmac_f32 v236, v16, v4
    v_mul_f32 v237, v237, v3
    v_fmac_f32 v237, v17, v4
    v_mul_f32 v238, v238, v3
    v_fmac_f32 v238, v18, v4
    v_mul_f32 v239, v239, v3
    v_fmac_f32 v239, v19, v4
    v_mul_f32 v240, v240, v3
    v_fmac_f32 v240, v20, v4
    v_mul_f32 v241, v241, v3
    v_fmac_f32 v241, v21, v4
    v_mul_f32 v242, v242, v3
    v_fmac_f32 v242, v22, v4
    v_mul_f32 v243, v243, v3
    v_fmac_f32 v243, v23, v4
L_fm1_a:
    s_sub_u32 s71, 2, s94
    s_and_b32 s71, s71, 3
    s_cmp_ge_u32 s71, s95
    s_cbranch_scc1 L_fm2_a
    ds_read_b64 v[24:25], v5 offset:8192
    ds_read_b128 v[16:19], v6 offset:8192
    ds_read_b128 v[20:23], v6 offset:9216
    s_waitcnt lgkmcnt(0)
    s_mov_b64 exec, 1
    ds_write_b32 v7, v8 offset:44
    s_mov_b64 exec, -1
    v_max_f32 v2, v244, v24
    v_sub_f32 v3, v244, v2
    v_sub_f32 v4, v24, v2
    v_exp_f32 v3, v3
    v_exp_f32 v4, v4
    v_mov_b32 v244, v2
    v_mul_f32 v245, v245, v3
    v_fmac_f32 v245, v25, v4
    v_mul_f32 v236, v236, v3
    v_fmac_f32 v236, v16, v4
    v_mul_f32 v237, v237, v3
    v_fmac_f32 v237, v17, v4
    v_mul_f32 v238, v238, v3
    v_fmac_f32 v238, v18, v4
    v_mul_f32 v239, v239, v3
    v_fmac_f32 v239, v19, v4
    v_mul_f32 v240, v240, v3
    v_fmac_f32 v240, v20, v4
    v_mul_f32 v241, v241, v3
    v_fmac_f32 v241, v21, v4
    v_mul_f32 v242, v242, v3
    v_fmac_f32 v242, v22, v4
    v_mul_f32 v243, v243, v3
    v_fmac_f32 v243, v23, v4
L_fm2_a:
    s_sub_u32 s71, 3, s94
    s_and_b32 s71, s71, 3
    s_cmp_ge_u32 s71, s95
    s_cbranch_scc1 L_fm3_a
    ds_read_b64 v[24:25], v5 offset:12288
    ds_read_b128 v[16:19], v6 offset:12288
    ds_read_b128 v[20:23], v6 offset:13312
    s_waitcnt lgkmcnt(0)
    s_mov_b64 exec, 1
    ds_write_b32 v7, v8 offset:60
    s_mov_b64 exec, -1
    v_max_f32 v2, v244, v24
    v_sub_f32 v3, v244, v2
    v_sub_f32 v4, v24, v2
    v_exp_f32 v3, v3
    v_exp_f32 v4, v4
    v_mov_b32 v244, v2
    v_mul_f32 v245, v245, v3
    v_fmac_f32 v245, v25, v4
    v_mul_f32 v236, v236, v3
    v_fmac_f32 v236, v16, v4
    v_mul_f32 v237, v237, v3
    v_fmac_f32 v237, v17, v4
    v_mul_f32 v238, v238, v3
    v_fmac_f32 v238, v18, v4
    v_mul_f32 v239, v239, v3
    v_fmac_f32 v239, v19, v4
    v_mul_f32 v240, v240, v3
    v_fmac_f32 v240, v20, v4
    v_mul_f32 v241, v241, v3
    v_fmac_f32 v241, v21, v4
    v_mul_f32 v242, v242, v3
    v_fmac_f32 v242, v22, v4
    v_mul_f32 v243, v243, v3
    v_fmac_f32 v243, v23, v4
L_fm3_a:
    s_lshl_b32 s72, s96, 5
    s_add_u32 s72, s72, s60
    s_lshl_b32 s72, s72, 3
    s_add_u32 s72, s72, s61
    s_mul_i32 s93, s72, 2304
    v_lshlrev_b32 v2, 3, v1
    buffer_store_dwordx4 v[236:239], v32, s[48:51], s93 offen sc1
    buffer_store_dwordx4 v[240:243], v32, s[48:51], s93 offen offset:1024 sc1
    s_mov_b64 exec, 0xffff
    buffer_store_dwordx2 v[244:245], v2, s[48:51], s93 offen offset:2048 sc1
    s_mov_b64 exec, -1
    buffer_load_dwordx2 v[246:247], v8, s[56:59], 0 offen
    s_mov_b32 s75, 1
    s_branch L_noflush_a
L_rectry:
    s_cmp_eq_u32 s13, 2
    s_cbranch_scc1 L_rs_check
    s_cmp_eq_u32 s13, 3
    s_cbranch_scc1 L_rs_merge
L_rs_poll:
    v_mov_b32 v2, 0
    s_mov_b32 s71, 268435456
    s_cmp_lg_u32 s15, 0
    s_cbranch_scc1 L_pn1
    buffer_load_dwordx2 v[16:17], v2, s[56:59], 0 offen
    s_branch L_pn2
L_pn1:
    buffer_load_dwordx2 v[16:17], v2, s[56:59], 0 offen sc1
L_pn2:
    s_mov_b32 s15, 1
    s_mov_b64 exec, s[88:89]
    buffer_load_dwordx2 v[18:19], v234, s[48:51], s71 offen sc1
    s_mov_b64 exec, -1
    s_mov_b32 s13, 2
    s_cmp_eq_u32 s14, 0
    s_cbranch_scc1 L_loop_go
L_rs_check:
    s_waitcnt vmcnt(0)
    s_mov_b64 exec, s[88:89]
    v_cmp_ne_u64 vcc, v[16:17], v[18:19]
    v_cmp_eq_u32 s[90:91], 0, v16
    s_mov_b64 exec, -1
    s_nop 2
    s_or_b64 vcc, vcc, s[90:91]
    s_cmp_eq_u64 vcc, 0
    s_cbranch_scc1 L_ready
    s_mov_b32 s13, 0
    s_cmp_eq_u32 s14, 0
    s_cbranch_scc1 L_loop_go
    s_sleep 8
    s_add_u32 s97, s97, 1
    s_cmp_lt_u32 s97, 0x200000
    s_cbranch_scc1 L_rs_poll
L_ready:
    s_mov_b32 s83, s81
    s_add_u32 s84, s81, s82
L_rs_issue:
    s_mov_b32 s95, 0
    v_cmp_ge_u32 vcc, s83, v13
    s_nop 3
    s_bcnt1_i32_b64 s96, vcc
    s_lshl_b32 s71, s60, 5
    v_readlane_b32 s72, v13, s96
    s_add_u32 s71, s71, s96
    s_lshl_b32 s71, s71, 3
    s_add_u32 s71, s71, s61
    s_mul_i32 s93, s71, 2304
    s_min_u32 s83, s72, s84
    buffer_load_dwordx2 v[16:17], v235, s[48:51], s93 offen sc1
    buffer_load_dwordx2 v[18:19], v232, s[48:51], s93 offen sc1
    s_mov_b32 s95, 1
    s_cmp_ge_u32 s83, s84
    s_cbranch_scc1 L_rs_issued
    v_cmp_ge_u32 vcc, s83, v13
    s_nop 3
    s_bcnt1_i32_b64 s96, vcc
    s_lshl_b32 s71, s60, 5
    v_readlane_b32 s72, v13, s96
    s_add_u32 s71, s71, s96
    s_lshl_b32 s71, s71, 3
    s_add_u32 s71, s71, s61
    s_mul_i32 s93, s71, 2304
    s_min_u32 s83, s72, s84
    buffer_load_dwordx2 v[20:21], v235, s[48:51], s93 offen sc1
    buffer_load_dwordx2 v[22:23], v232, s[48:51], s93 offen sc1
    s_mov_b32 s95, 2
    s_cmp_ge_u32 s83, s84
    s_cbranch_scc1 L_rs_issued
    v_cmp_ge_u32 vcc, s83, v13
    s_nop 3
    s_bcnt1_i32_b64 s96, vcc
    s_lshl_b32 s71, s60, 5
    v_readlane_b32 s72, v13, s96
    s_add_u32 s71, s71, s96
    s_lshl_b32 s71, s71, 3
    s_add_u32 s71, s71, s61
    s_mul_i32 s93, s71, 2304
    s_min_u32 s83, s72, s84
    buffer_load_dwordx2 v[24:25], v235, s[48:51], s93 offen sc1
    buffer_load_dwordx2 v[26:27], v232, s[48:51], s93 offen sc1
    s_mov_b32 s95, 3
    s_cmp_ge_u32 s83, s84
    s_cbranch_scc1 L_rs_issued
    v_cmp_ge_u32 vcc, s83, v13
    s_nop 3
    s_bcnt1_i32_b64 s96, vcc
    s_lshl_b32 s71, s60, 5
    v_readlane_b32 s72, v13, s96
    s_add_u32 s71, s71, s96
    s_lshl_b32 s71, s71, 3
    s_add_u32 s71, s71, s61
    s_mul_i32 s93, s71, 2304
    s_min_u32 s83, s72, s84
    buffer_load_dwordx2 v[28:29], v235, s[48:51], s93 offen sc1
    buffer_load_dwordx2 v[30:31], v232, s[48:51], s93 offen sc1
    s_mov_b32 s95, 4
L_rs_issued:
    s_mov_b32 s13, 3
    s_cmp_eq_u32 s14, 0
    s_cbranch_scc1 L_loop_go
L_rs_merge:
    s_waitcnt vmcnt(0)
    v_max_f32 v2, v228, v16
    v_sub_f32 v3, v228, v2
    v_sub_f32 v4, v16, v2
    v_exp_f32 v3, v3
    v_exp_f32 v4, v4
    v_mov_b32 v228, v2
    v_mul_f32 v229, v229, v3
    v_mul_f32 v230, v230, v3
    v_mul_f32 v231, v231, v3
    v_fmac_f32 v229, v17, v4
    v_fmac_f32 v230, v18, v4
    v_fmac_f32 v231, v19, v4
    s_cmp_le_u32 s95, 1
    s_cbranch_scc1 L_rs_merged
    v_max_f32 v2, v228, v20
    v_sub_f32 v3, v228, v2
    v_sub_f32 v4, v20, v2
    v_exp_f32 v3, v3
    v_exp_f32 v4, v4
    v_mov_b32 v228, v2
    v_mul_f32 v229, v229, v3
    v_mul_f32 v230, v230, v3
    v_mul_f32 v231, v231, v3
    v_fmac_f32 v229, v21, v4
    v_fmac_f32 v230, v22, v4
    v_fmac_f32 v231, v23, v4
    s_cmp_le_u32 s95, 2
    s_cbranch_scc1 L_rs_merged
    v_max_f32 v2, v228, v24
    v_sub_f32 v3, v228, v2
    v_sub_f32 v4, v24, v2
    v_exp_f32 v3, v3
    v_exp_f32 v4, v4
    v_mov_b32 v228, v2
    v_mul_f32 v229, v229, v3
    v_mul_f32 v230, v230, v3
    v_mul_f32 v231, v231, v3
    v_fmac_f32 v229, v25, v4
    v_fmac_f32 v230, v26, v4
    v_fmac_f32 v231, v27, v4
    s_cmp_le_u32 s95, 3
    s_cbranch_scc1 L_rs_merged
    v_max_f32 v2, v228, v28
    v_sub_f32 v3, v228, v2
    v_sub_f32 v4, v28, v2
    v_exp_f32 v3, v3
    v_exp_f32 v4, v4
    v_mov_b32 v228, v2
    v_mul_f32 v229, v229, v3
    v_mul_f32 v230, v230, v3
    v_mul_f32 v231, v231, v3
    v_fmac_f32 v229, v29, v4
    v_fmac_f32 v230, v30, v4
    v_fmac_f32 v231, v31, v4
L_rs_merged:
    s_cmp_lt_u32 s83, s84
    s_cbranch_scc1 L_rs_issue
    s_mov_b32 s13, 1
    s_cmp_eq_u32 s14, 0
    s_cbranch_scc1 L_loop_go
    s_branch L_store
L_code_end:
.section .rodata,"a"
.p2align 6
.amdhsa_kernel standalone__paged_block_table_kv_pagedattention__sampling_kernel
  .amdhsa_next_free_vgpr 256
  .amdhsa_next_free_sgpr 102
  .amdhsa_accum_offset 256
  .amdhsa_group_segment_fixed_size 0
  .amdhsa_kernarg_size 64
  .amdhsa_user_sgpr_count 2
  .amdhsa_user_sgpr_kernarg_segment_ptr 1
  .amdhsa_system_sgpr_workgroup_id_x 1
.end_amdhsa_kernel
```
